```python
import torch

def _softmax(x, axis=-1):
    return torch.softmax(x, dim=axis)
def _gelu(x):
    return torch.nn.functional.gelu(x, approximate="tanh")
def _silu(x):
    return torch.nn.functional.silu(x)
def _sigmoid(x):
    return torch.sigmoid(x)
def _layernorm(x, axis=-1, eps=1e-5):
    m = x.mean(dim=axis, keepdim=True)
    v = x.var(dim=axis, keepdim=True, unbiased=False)
    return (x - m) / torch.sqrt(v + eps)
def _scatter_add(tgt, idx, src, axis=0):
    return tgt.clone().index_add_(axis, idx, src)
def _segment_sum(src, seg, n):
    out = torch.zeros((n,) + src.shape[1:], dtype=src.dtype)
    return out.index_add_(0, seg, src)
def _pad(x, pw):
    flat = tuple(v for pair in reversed(pw) for v in pair)
    return torch.nn.functional.pad(x, flat)

kernel_name = 'standalone__kernel_systems_refs_featgraph__graph'

def setup_inputs():

    _w = (lambda a: (lambda t: t.to(torch.bfloat16) if t.is_floating_point() else t)(torch.as_tensor(a)))
    N, deg, D = 12500, 32, 128
    E = N * deg
    scale = D ** -0.5
    src = (lambda lo, hi, *s: torch.randint(lo, hi, s))(0, N, E).to(torch.int64)
    dst = (lambda lo, hi, *s: torch.randint(lo, hi, s))(0, N, E).to(torch.int64)
    return {
        "x": _w((lambda *s: torch.randn(*s, dtype=torch.bfloat16) * 0.8)(N, D)),
        "src": _w(src),
        "dst": _w(dst),
        "w_q": _w((lambda *s: torch.randn(*s, dtype=torch.bfloat16) * 0.8)(D, D) * scale),
        "w_v": _w((lambda *s: torch.randn(*s, dtype=torch.bfloat16) * 0.05)(D, D) * scale),
    }

def reference(x, src, dst, w_q, w_v):
    N, D = x.shape
    xs = x[src]
    xd = x[dst]
    q = xd @ w_q
    logits = torch.einsum('ed,ed->e', xs, q) * (float(D) ** -0.5)
    alpha = _sigmoid(logits)
    msg = alpha[:, None] * (xs @ w_v)
    return _segment_sum(msg, dst, N)
```

```asm
; @launch grid=(256,1,1) block=(1024,1,1) lds=147968
.amdgcn_target "amdgcn-amd-amdhsa--gfx950"
.text
.globl standalone__kernel_systems_refs_featgraph__graph_kernel
.p2align 8
.type standalone__kernel_systems_refs_featgraph__graph_kernel,@function
standalone__kernel_systems_refs_featgraph__graph_kernel:
  s_load_dwordx8 s[4:11], s[0:1], 0
  s_load_dwordx8 s[64:71], s[0:1], 32
  s_cmp_ge_u32 s2, 256
  s_cbranch_scc1 B_done
  v_lshlrev_b32 v1, 4, v0
  v_readfirstlane_b32 s36, v0
  v_lshlrev_b32 v2, 2, v0
  v_and_b32 v2, 0xc0, v2
  v_xor_b32 v2, v2, v1
  v_and_b32 v3, 0xf0, v0
  v_xor_b32 v3, v3, v1
  s_lshr_b32 s36, s36, 6
  s_mov_b32 s14, 3200000
  s_mov_b32 s15, 0x20000
  s_cmp_lt_u32 s36, 14
  s_cbranch_scc1 F_nocw
  s_getpc_b64 s[98:99]
F_pc:
  v_and_b32 v120, 127, v0
  v_lshlrev_b32 v120, 7, v120
  v_min_u32 v120, F_code_end-F_pc-4, v120
  global_load_dword v121, v120, s[98:99]
F_nocw:
  v_mov_b32 v50, 0
  v_mov_b32 v51, 0
  v_mov_b32 v52, 0
  v_mov_b32 v53, 0
  s_cmp_ge_u32 s2, 128
  s_cbranch_scc1 F_nopart
  s_mul_i32 s3, s2, 12544
  v_add_u32 v30, s3, v1
  s_cmp_eq_u32 s2, 127
  s_movk_i32 s3, 784
  s_cselect_b32 s3, 432, s3
  v_cmp_gt_u32 s[40:41], s3, v0
  v_mov_b32 v54, -1
  v_mov_b32 v55, -1
  v_mov_b32 v56, -1
  v_mov_b32 v57, -1
  s_mov_b64 exec, s[40:41]
  s_waitcnt lgkmcnt(0)
  s_cbranch_execz F_noload
  global_load_dwordx4 v[74:77], v30, s[8:9] nt
  global_load_dwordx4 v[78:81], v30, s[6:7] nt
F_noload:
  s_mov_b64 exec, -1
  ds_write_b128 v1, v[54:57]
  ds_write_b128 v1, v[54:57] offset:16384
  ds_write_b128 v1, v[50:53] offset:32768
  s_mov_b64 s[12:13], s[4:5]
  s_waitcnt lgkmcnt(0)
  s_load_dword s35, s[70:71], 0
  s_barrier
  s_lshl_b32 s56, s36, 10
  s_lshr_b32 s57, s36, 1
  s_lshl_b32 s57, s57, 3
  s_add_u32 s56, s56, s57
  s_add_u32 m0, s56, 65536
  v_add_u32 v32, 0x4000, v2
  global_load_lds_dwordx4 v2, s[10:11]
  s_add_u32 m0, s56, 81984
  s_nop 0
  global_load_lds_dwordx4 v32, s[10:11]
  s_and_b32 s56, s36, 3
  s_lshl_b32 s57, s56, 2
  s_lshl_b32 s72, s56, 6
  s_and_b32 s58, s36, 12
  s_lshl_b32 s58, s58, 2
  v_and_b32 v30, 7, v0
  v_lshlrev_b32 v30, 4, v30
  v_or_b32 v4, 0x7fc00000, v30
  v_add_u32 v5, 512, v30
  v_and_b32 v31, 16, v0
  v_add_u32 v31, v31, v30
  v_subrev_u32 v6, 512, v31
  v_bfe_u32 v31, v0, 3, 3
  s_xor_b32 s59, s36, 8
  s_lshl_b32 s59, s59, 4
  v_add_u32 v31, s59, v31
  v_lshl_add_u32 v119, v31, 7, v30
  s_movk_i32 s59, 17024
  v_mad_u32_u24 v11, v31, s59, v30
  v_and_b32 v31, 3, v0
  v_mul_u32_u24 v7, 0x5555, v31
  s_lshl_b32 s59, s36, 3
  s_and_b32 s59, s59, 48
  v_bfe_u32 v32, v0, 3, 3
  v_mul_u32_u24 v122, 144, v32
  v_add_u32 v122, v122, v30
  v_add_u32 v32, s59, v32
  v_lshl_add_u32 v18, v32, 8, v30
  v_cmp_gt_u32 vcc, 49, v32
  v_cmp_gt_u32 s[100:101], 41, v32
  v_bfrev_b32 v32, 2
  v_cndmask_b32 v18, v32, v18, vcc
  v_and_b32 v30, 15, v0
  v_xor_b32 v31, s57, v30
  v_and_b32 v32, 12, v0
  v_and_b32 v33, 48, v0
  s_mov_b32 s59, 65536
  v_lshl_add_u32 v8, v33, 7, s59
  v_lshl_add_u32 v8, v32, 6, v8
  v_lshl_add_u32 v8, v31, 4, v8
  v_bfe_u32 v31, v0, 4, 2
  v_xor_b32 v32, v31, v30
  v_add_u32 v33, s58, v30
  s_mov_b32 s59, 98560
  v_lshl_add_u32 v9, v33, 8, s59
  v_lshl_add_u32 v9, v32, 4, v9
  v_cmp_gt_u32 s[74:75], 49, v33
  v_mul_u32_u24 v33, 784, v33
  s_lshl_b32 s59, s36, 3
  s_and_b32 s59, s59, 48
  v_add_u32 v32, s59, v30
  v_mul_u32_u24 v32, 784, v32
  v_lshl_add_u32 v16, v31, 5, v32
  v_lshl_add_u32 v10, v31, 4, v33
  v_add_u32 v10, s72, v10
  s_mov_b32 s59, 39488
  v_lshl_add_u32 v13, v31, 2, s59
  v_mul_u32_u24 v30, 144, v30
  s_mul_i32 s57, s36, 2304
  s_add_u32 s57, s57, s59
  v_lshl_add_u32 v30, v31, 4, v30
  v_add_u32 v17, s57, v30
  v_add_u32 v122, s57, v122
  v_and_b32 v30, 8, v0
  s_lshl_b32 s57, s36, 5
  v_lshl_add_u32 v12, v30, 1, s57
  v_bfe_u32 v30, v0, 5, 1
  s_lshl_b32 s57, s36, 3
  v_lshl_add_u32 v14, v30, 2, s57
  v_and_b32 v30, 31, v0
  s_mov_b32 s59, 56892
  v_lshl_add_u32 v15, v30, 2, s59
  v_and_b32 v30, 63, v0
  v_mul_u32_u24 v19, 784, v30
  s_mov_b32 s54, 0x400000
  s_mov_b32 s55, 0x3fff00
  s_mov_b32 s62, 0
  s_mov_b32 s48, 0x00ff00ff
  s_mov_b32 s49, 0xff00ff00
  v_mov_b32 v38, 0
  v_mov_b32 v39, 0
  v_mov_b32 v40, 0
  v_mov_b32 v41, 0
  v_mov_b32 v42, 0
  v_mov_b32 v43, 0
  v_mov_b32 v44, 0
  v_mov_b32 v45, 0
  v_mov_b32 v46, 0
  v_mov_b32 v47, 0
  v_mov_b32 v48, 0
  v_mov_b32 v49, 0
  v_bfe_u32 v124, v1, 2, 8
  v_mov_b32 v125, 0x7fc00000
  v_mov_b32 v126, 4
  s_mov_b64 s[50:51], 0
  s_mov_b64 s[52:53], 0
  s_mul_i32 s3, s2, 17024
  v_min_u32 v127, 16368, v1
  v_add_u32 v127, s3, v127
  s_mov_b32 s61, 0xbe0293ee
  s_mov_b32 s60, 40000
  s_lshr_b32 s3, s2, 3
  s_mul_i32 s3, s3, 400
  s_mul_i32 s56, s36, 25
  s_add_u32 s3, s3, s56
  s_lshl_b32 s98, s3, 7
  v_lshlrev_b32 v123, 5, v124
  s_mov_b64 exec, s[40:41]
  s_cbranch_execz F_idle
  s_movk_i32 s58, 21400
  v_mov_b32 v34, 4
  s_movk_i32 s59, -49
  s_waitcnt vmcnt(3)
  v_mul_u32_u24 v82, s58, v74
  v_mul_u32_u24 v83, s58, v75
  v_mul_u32_u24 v84, s58, v76
  v_mul_u32_u24 v85, s58, v77
  v_lshrrev_b32 v82, 20, v82
  v_lshrrev_b32 v83, 20, v83
  v_lshrrev_b32 v84, 20, v84
  v_lshrrev_b32 v85, 20, v85
  v_mad_i32_i24 v86, v82, s59, v74
  v_lshlrev_b32 v82, 2, v82
  ds_add_rtn_u32 v90, v82, v34 offset:32768
  v_mad_i32_i24 v87, v83, s59, v75
  v_lshlrev_b32 v83, 2, v83
  ds_add_rtn_u32 v91, v83, v34 offset:32768
  v_mad_i32_i24 v88, v84, s59, v76
  v_lshlrev_b32 v84, 2, v84
  ds_add_rtn_u32 v92, v84, v34 offset:32768
  v_mad_i32_i24 v89, v85, s59, v77
  v_lshlrev_b32 v85, 2, v85
  ds_add_rtn_u32 v93, v85, v34 offset:32768
  s_waitcnt vmcnt(2)
  s_mov_b64 exec, -1
  s_lshl_b32 s56, s36, 10
  s_add_u32 m0, s56, 98560
  s_mul_i32 s57, s2, 12544
  s_cmp_gt_u32 s36, 12
  s_cbranch_scc1 F_nx0
  buffer_load_dwordx4 v3, s[12:15], s57 offen lds
F_nx0:
  s_mov_b64 exec, s[40:41]
  v_lshl_add_u32 v86, v78, 8, v86
  v_lshl_add_u32 v87, v79, 8, v87
  v_lshl_add_u32 v88, v80, 8, v88
  v_lshl_add_u32 v89, v81, 8, v89
  s_movk_i32 s58, 124
  s_waitcnt lgkmcnt(0)
  v_max3_u32 v35, v90, v91, v92
  v_max_u32 v35, v35, v93
  v_cmp_lt_u32 vcc, s58, v35
  s_cmp_lg_u64 vcc, 0
  s_cbranch_scc1 F_ovf
F_ovfdone:
  v_add_u32 v35, v90, v82
  v_bfe_u32 v90, v90, 5, 2
  v_and_b32 v35, 28, v35
  v_lshl_add_u32 v35, v82, 3, v35
  v_add_lshl_u32 v90, v35, v90, 2
  ds_write_b32 v90, v86
  v_add_u32 v35, v91, v83
  v_bfe_u32 v91, v91, 5, 2
  v_and_b32 v35, 28, v35
  v_lshl_add_u32 v35, v83, 3, v35
  v_add_lshl_u32 v91, v35, v91, 2
  ds_write_b32 v91, v87
  v_add_u32 v35, v92, v84
  v_bfe_u32 v92, v92, 5, 2
  v_and_b32 v35, 28, v35
  v_lshl_add_u32 v35, v84, 3, v35
  v_add_lshl_u32 v92, v35, v92, 2
  ds_write_b32 v92, v88
  v_add_u32 v35, v93, v85
  v_bfe_u32 v93, v93, 5, 2
  v_and_b32 v35, 28, v35
  v_lshl_add_u32 v35, v85, 3, v35
  v_add_lshl_u32 v93, v35, v93, 2
  ds_write_b32 v93, v89
F_placed:
  s_mov_b64 exec, -1
  v_mov_b32 v34, 33792
  s_waitcnt lgkmcnt(0)
  s_barrier
  ds_read_b32 v82, v34
  ds_read_b128 v[74:77], v119
  ds_read_b128 v[78:81], v119 offset:1024
  s_add_u32 s35, s35, 1
  s_lshl_b32 s24, s35, 22
  s_xor_b32 s25, s24, 0x6b400000
  s_xor_b32 s26, s24, 0xd6800000
  s_xor_b32 s27, s24, 0x41c00000
  s_add_u32 s28, s24, 1
  s_add_u32 s29, s25, 1
  s_add_u32 s30, s26, 1
  s_add_u32 s31, s27, 1
  s_lshl_b32 s3, s2, 7
  s_add_u32 s56, s70, s3
  s_addc_u32 s57, s71, 0
  s_add_u32 s58, s56, 136192
  s_addc_u32 s59, s57, 0
  s_waitcnt lgkmcnt(2)
  v_readfirstlane_b32 s99, v82
  s_cmp_lg_u32 s99, 0
  s_cbranch_scc1 F_cnt
F_cntdone:
  s_waitcnt lgkmcnt(1)
  v_add_u32 v74, s28, v74
  v_add_u32 v75, s29, v75
  v_add_u32 v76, s30, v76
  v_add_u32 v77, s31, v77
  global_store_dwordx4 v11, v[74:77], s[56:57] offset:2048 sc1
  s_waitcnt lgkmcnt(0)
  v_add_u32 v78, s28, v78
  v_add_u32 v79, s29, v79
  v_add_u32 v80, s30, v80
  v_add_u32 v81, s31, v81
  global_store_dwordx4 v11, v[78:81], s[58:59] offset:2048 sc1
  ds_write_b128 v119, v[50:53]
  ds_write_b128 v119, v[50:53] offset:1024
  ds_write_b128 v1, v[50:53] offset:32768
  ds_write_b128 v1, v[50:53] offset:49152
  s_waitcnt vmcnt(2) lgkmcnt(0)
  s_barrier
  s_branch F_join
F_nopart:
  s_waitcnt lgkmcnt(0)
  s_load_dword s35, s[70:71], 0
  s_mov_b64 s[12:13], s[4:5]
  s_lshl_b32 s56, s36, 10
  s_lshr_b32 s57, s36, 1
  s_lshl_b32 s57, s57, 3
  s_add_u32 s56, s56, s57
  s_add_u32 m0, s56, 65536
  v_add_u32 v32, 0x4000, v2
  global_load_lds_dwordx4 v2, s[10:11]
  s_add_u32 m0, s56, 81984
  s_nop 0
  global_load_lds_dwordx4 v32, s[10:11]
  ds_write_b128 v1, v[50:53] offset:0
  ds_write_b128 v1, v[50:53] offset:16384
  ds_write_b128 v1, v[50:53] offset:32768
  ds_write_b128 v1, v[50:53] offset:49152
  s_and_b32 s56, s36, 3
  s_lshl_b32 s57, s56, 2
  s_lshl_b32 s72, s56, 6
  s_and_b32 s58, s36, 12
  s_lshl_b32 s58, s58, 2
  v_and_b32 v30, 7, v0
  v_lshlrev_b32 v30, 4, v30
  v_or_b32 v4, 0x7fc00000, v30
  v_add_u32 v5, 512, v30
  v_and_b32 v31, 16, v0
  v_add_u32 v31, v31, v30
  v_subrev_u32 v6, 512, v31
  v_bfe_u32 v31, v0, 3, 3
  s_xor_b32 s59, s36, 8
  s_lshl_b32 s59, s59, 4
  v_add_u32 v31, s59, v31
  v_lshl_add_u32 v119, v31, 7, v30
  s_movk_i32 s59, 17024
  v_mad_u32_u24 v11, v31, s59, v30
  v_and_b32 v31, 3, v0
  v_mul_u32_u24 v7, 0x5555, v31
  s_lshl_b32 s59, s36, 3
  s_and_b32 s59, s59, 48
  v_bfe_u32 v32, v0, 3, 3
  v_mul_u32_u24 v122, 144, v32
  v_add_u32 v122, v122, v30
  v_add_u32 v32, s59, v32
  v_lshl_add_u32 v18, v32, 8, v30
  v_cmp_gt_u32 vcc, 49, v32
  v_cmp_gt_u32 s[100:101], 41, v32
  v_bfrev_b32 v32, 2
  v_cndmask_b32 v18, v32, v18, vcc
  v_and_b32 v30, 15, v0
  v_xor_b32 v31, s57, v30
  v_and_b32 v32, 12, v0
  v_and_b32 v33, 48, v0
  s_mov_b32 s59, 65536
  v_lshl_add_u32 v8, v33, 7, s59
  v_lshl_add_u32 v8, v32, 6, v8
  v_lshl_add_u32 v8, v31, 4, v8
  v_bfe_u32 v31, v0, 4, 2
  v_xor_b32 v32, v31, v30
  v_add_u32 v33, s58, v30
  s_mov_b32 s59, 98560
  v_lshl_add_u32 v9, v33, 8, s59
  v_lshl_add_u32 v9, v32, 4, v9
  v_cmp_gt_u32 s[74:75], 49, v33
  v_mul_u32_u24 v33, 784, v33
  s_lshl_b32 s59, s36, 3
  s_and_b32 s59, s59, 48
  v_add_u32 v32, s59, v30
  v_mul_u32_u24 v32, 784, v32
  v_lshl_add_u32 v16, v31, 5, v32
  v_lshl_add_u32 v10, v31, 4, v33
  v_add_u32 v10, s72, v10
  s_mov_b32 s59, 39488
  v_lshl_add_u32 v13, v31, 2, s59
  v_mul_u32_u24 v30, 144, v30
  s_mul_i32 s57, s36, 2304
  s_add_u32 s57, s57, s59
  v_lshl_add_u32 v30, v31, 4, v30
  v_add_u32 v17, s57, v30
  v_add_u32 v122, s57, v122
  v_and_b32 v30, 8, v0
  s_lshl_b32 s57, s36, 5
  v_lshl_add_u32 v12, v30, 1, s57
  v_bfe_u32 v30, v0, 5, 1
  s_lshl_b32 s57, s36, 3
  v_lshl_add_u32 v14, v30, 2, s57
  v_and_b32 v30, 31, v0
  s_mov_b32 s59, 56892
  v_lshl_add_u32 v15, v30, 2, s59
  v_and_b32 v30, 63, v0
  v_mul_u32_u24 v19, 784, v30
  s_mov_b32 s54, 0x400000
  s_mov_b32 s55, 0x3fff00
  s_mov_b32 s62, 0
  s_mov_b32 s48, 0x00ff00ff
  s_mov_b32 s49, 0xff00ff00
  v_mov_b32 v38, 0
  v_mov_b32 v39, 0
  v_mov_b32 v40, 0
  v_mov_b32 v41, 0
  v_mov_b32 v42, 0
  v_mov_b32 v43, 0
  v_mov_b32 v44, 0
  v_mov_b32 v45, 0
  v_mov_b32 v46, 0
  v_mov_b32 v47, 0
  v_mov_b32 v48, 0
  v_mov_b32 v49, 0
  v_bfe_u32 v124, v1, 2, 8
  v_mov_b32 v125, 0x7fc00000
  v_mov_b32 v126, 4
  s_mov_b64 s[50:51], 0
  s_mov_b64 s[52:53], 0
  s_mul_i32 s3, s2, 17024
  v_min_u32 v127, 16368, v1
  v_add_u32 v127, s3, v127
  s_mov_b32 s61, 0xbe0293ee
  s_mov_b32 s60, 40000
  s_lshr_b32 s3, s2, 3
  s_mul_i32 s3, s3, 400
  s_mul_i32 s56, s36, 25
  s_add_u32 s3, s3, s56
  s_lshl_b32 s98, s3, 7
  v_lshlrev_b32 v123, 5, v124
  s_waitcnt vmcnt(0)
  s_lshl_b32 s56, s36, 10
  s_add_u32 m0, s56, 98560
  s_mul_i32 s57, s2, 12544
  s_cmp_gt_u32 s36, 12
  s_cbranch_scc1 F_nx1
  buffer_load_dwordx4 v3, s[12:15], s57 offen lds
F_nx1:
  s_waitcnt vmcnt(0) lgkmcnt(0)
F_z:
  s_add_u32 s35, s35, 1
  s_lshl_b32 s24, s35, 22
  s_xor_b32 s25, s24, 0x6b400000
  s_xor_b32 s26, s24, 0xd6800000
  s_xor_b32 s27, s24, 0x41c00000
  s_barrier
F_join:
  s_lshl_b32 s56, s36, 10
  s_lshr_b32 s57, s36, 1
  s_lshl_b32 s57, s57, 3
  s_add_u32 s56, s56, s57
  s_add_u32 m0, s56, 114944
  v_add_u32 v32, 0x4000, v2
  global_load_lds_dwordx4 v2, s[64:65]
  s_add_u32 m0, s56, 131392
  s_nop 0
  global_load_lds_dwordx4 v32, s[64:65]
  v_bfe_u32 v118, v0, 4, 2
  v_lshl_add_u32 v118, v118, 3, v8
  ds_read_b64_tr_b16 v[74:75], v118 offset:0
  ds_read_b64_tr_b16 v[76:77], v118 offset:1024
  ds_read_b64_tr_b16 v[90:91], v118 offset:8
  ds_read_b64_tr_b16 v[92:93], v118 offset:1032
  ds_read_b128 v[58:61], v9
  ds_read_b64_tr_b16 v[78:79], v118 offset:8224
  ds_read_b64_tr_b16 v[80:81], v118 offset:9248
  ds_read_b64_tr_b16 v[94:95], v118 offset:8232
  ds_read_b64_tr_b16 v[96:97], v118 offset:9256
  v_xor_b32 v22, 64, v9
  ds_read_b128 v[62:65], v22
  ds_read_b64_tr_b16 v[82:83], v118 offset:16448
  ds_read_b64_tr_b16 v[84:85], v118 offset:17472
  ds_read_b64_tr_b16 v[98:99], v118 offset:16456
  ds_read_b64_tr_b16 v[100:101], v118 offset:17480
  v_xor_b32 v23, 128, v9
  ds_read_b128 v[66:69], v23
  ds_read_b64_tr_b16 v[86:87], v118 offset:24672
  ds_read_b64_tr_b16 v[88:89], v118 offset:25696
  ds_read_b64_tr_b16 v[102:103], v118 offset:24680
  ds_read_b64_tr_b16 v[104:105], v118 offset:25704
  v_xor_b32 v24, 192, v9
  ds_read_b128 v[70:73], v24
  s_waitcnt lgkmcnt(15)
  v_mfma_f32_16x16x32_bf16 v[50:53], v[74:77], v[58:61], 0
  v_mfma_f32_16x16x32_bf16 v[54:57], v[90:93], v[58:61], 0
  s_waitcnt lgkmcnt(10)
  v_mfma_f32_16x16x32_bf16 v[50:53], v[78:81], v[62:65], v[50:53]
  v_mfma_f32_16x16x32_bf16 v[54:57], v[94:97], v[62:65], v[54:57]
  s_waitcnt lgkmcnt(5)
  v_mfma_f32_16x16x32_bf16 v[50:53], v[82:85], v[66:69], v[50:53]
  v_mfma_f32_16x16x32_bf16 v[54:57], v[98:101], v[66:69], v[54:57]
  s_waitcnt lgkmcnt(0)
  v_mfma_f32_16x16x32_bf16 v[50:53], v[86:89], v[70:73], v[50:53]
  v_mfma_f32_16x16x32_bf16 v[54:57], v[102:105], v[70:73], v[54:57]
  global_load_dwordx4 v[106:109], v127, s[70:71] offset:2048 sc1
  s_mov_b64 exec, s[74:75]
  s_nop 6
  v_pk_mul_f32 v[50:51], v[50:51], s[60:61] op_sel:[0,1] op_sel_hi:[1,1]
  v_pk_mul_f32 v[52:53], v[52:53], s[60:61] op_sel:[0,1] op_sel_hi:[1,1]
  v_pk_mul_f32 v[54:55], v[54:55], s[60:61] op_sel:[0,1] op_sel_hi:[1,1]
  v_pk_mul_f32 v[56:57], v[56:57], s[60:61] op_sel:[0,1] op_sel_hi:[1,1]
  v_cvt_pk_bf16_f32 v58, v50, v51
  v_cvt_pk_bf16_f32 v59, v52, v53
  v_cvt_pk_bf16_f32 v60, v54, v55
  v_cvt_pk_bf16_f32 v61, v56, v57
  ds_write_b128 v10, v[58:61] offset:1296
  s_mov_b64 exec, -1
  v_mov_b64 v[50:51], 0
  v_mov_b64 v[52:53], 0
  v_mov_b64 v[54:55], 0
  v_mov_b64 v[56:57], 0
F_wait:
  s_waitcnt vmcnt(0)
  v_xor_b32 v30, s24, v106
  v_bitop3_b32 v30, v107, s25, v30 bitop3:0xbe
  v_bitop3_b32 v30, v108, s26, v30 bitop3:0xbe
  v_bitop3_b32 v30, v109, s27, v30 bitop3:0xbe
  v_cmp_le_u32 vcc, s54, v30
  s_mov_b64 exec, vcc
  s_cbranch_execz F_polled
  global_load_dwordx4 v[106:109], v127, s[70:71] offset:2048 sc1
F_poll:
  s_sleep 4
  s_sub_u32 s60, s60, 1
  s_cbranch_scc1 F_giveup
  global_load_dwordx4 v[106:109], v127, s[70:71] offset:2048 sc1
  s_waitcnt vmcnt(1)
  v_xor_b32 v30, s24, v106
  v_bitop3_b32 v30, v107, s25, v30 bitop3:0xbe
  v_bitop3_b32 v30, v108, s26, v30 bitop3:0xbe
  v_bitop3_b32 v30, v109, s27, v30 bitop3:0xbe
  v_cmp_le_u32 vcc, s54, v30
  s_mov_b64 exec, vcc
  s_cbranch_execnz F_poll
F_polled:
  s_mov_b64 exec, -1
  s_mov_b32 exec_lo, 0x1fff
  s_mov_b32 exec_hi, 0x0
  buffer_load_dword v2, v123, s[12:15], s98 offen
  s_mov_b64 exec, -1
B_build:
  v_lshlrev_b32_sdwa v114, 2, v106 dst_sel:DWORD dst_unused:UNUSED_PAD src0_sel:DWORD src1_sel:BYTE_0
  v_lshlrev_b32_sdwa v115, 2, v107 dst_sel:DWORD dst_unused:UNUSED_PAD src0_sel:DWORD src1_sel:BYTE_0
  v_lshlrev_b32_sdwa v116, 2, v108 dst_sel:DWORD dst_unused:UNUSED_PAD src0_sel:DWORD src1_sel:BYTE_0
  v_lshlrev_b32_sdwa v117, 2, v109 dst_sel:DWORD dst_unused:UNUSED_PAD src0_sel:DWORD src1_sel:BYTE_0
  v_max3_u32 v30, v114, v115, v116
  v_max_u32 v30, v30, v117
  v_cmp_lt_u32 vcc, 0xf8, v30
  s_cmp_lg_u64 vcc, 0
  s_cbranch_scc1 B_mark
B_nomark:
  v_cmp_ne_u32 s[40:41], 0, v114
  v_cmp_ne_u32 s[42:43], 0, v115
  v_cmp_ne_u32 s[44:45], 0, v116
  v_cmp_ne_u32 s[46:47], 0, v117
  s_mov_b64 exec, s[40:41]
  ds_add_rtn_u32 v110, v114, v126 offset:39200
  s_mov_b64 exec, s[42:43]
  ds_add_rtn_u32 v111, v115, v126 offset:39200
  s_mov_b64 exec, s[44:45]
  s_cbranch_execz B_sa2
  ds_add_rtn_u32 v112, v116, v126 offset:39200
B_sa2:
  s_mov_b64 exec, s[46:47]
  s_cbranch_execz B_sa3
  ds_add_rtn_u32 v113, v117, v126 offset:39200
B_sa3:
  s_mov_b64 exec, -1
  v_bitop3_b32 v118, v106, s55, v125 bitop3:0x6a
  v_bitop3_b32 v119, v107, s55, v125 bitop3:0x6a
  v_bitop3_b32 v120, v108, s55, v125 bitop3:0x6a
  v_bitop3_b32 v121, v109, s55, v125 bitop3:0x6a
  s_waitcnt lgkmcnt(0)
  s_barrier
  ds_read_b32 v31, v124 offset:39200
  ds_read_b32 v37, v126 offset:39468
  s_lshl_b32 s58, s36, 2
  s_mov_b32 s59, s36
  s_waitcnt lgkmcnt(1)
  v_add_u32 v31, 12, v31
  v_lshrrev_b32 v31, 4, v31
  s_nop 1
  v_add_u32_dpp v32, v31, v31 row_shr:1 row_mask:0xf bank_mask:0xf bound_ctrl:0
  s_nop 1
  v_add_u32_dpp v32, v32, v32 row_shr:2 row_mask:0xf bank_mask:0xf
  s_nop 1
  v_add_u32_dpp v32, v32, v32 row_shr:4 row_mask:0xf bank_mask:0xf
  s_nop 1
  v_add_u32_dpp v32, v32, v32 row_shr:8 row_mask:0xf bank_mask:0xf
  s_nop 1
  v_add_u32_dpp v32, v32, v32 row_bcast:15 row_mask:0xa bank_mask:0xf
  s_nop 1
  v_add_u32_dpp v32, v32, v32 row_bcast:31 row_mask:0xc bank_mask:0xf
  s_nop 0
  v_sub_u32 v30, v32, v31
  v_readlane_b32 s37, v32, 63
  v_lshlrev_b32 v32, 4, v30
  ds_bpermute_b32 v114, v114, v32
  ds_bpermute_b32 v115, v115, v32
  s_cmp_eq_u64 s[44:45], 0
  s_cbranch_scc1 B_sb2
  ds_bpermute_b32 v116, v116, v32
B_sb2:
  s_cmp_eq_u64 s[46:47], 0
  s_cbranch_scc1 B_sb3
  ds_bpermute_b32 v117, v117, v32
B_sb3:
  v_lshl_add_u32 v30, v30, 2, s58
  s_add_u32 s37, s37, 31
  s_lshr_b32 s37, s37, 5
B_qn:
  v_cmp_lt_u32 vcc, s59, v31
  s_add_u32 s59, s59, 16
  v_cmp_lt_u32 s[56:57], s59, v31
  s_mov_b64 exec, vcc
  ds_write_b32 v30, v19 offset:56896
  s_mov_b64 exec, -1
  s_cmp_lg_u64 s[56:57], 0
  s_cbranch_scc1 B_qnmore
  v_cmp_lt_u32 vcc, s37, v31
  s_mov_b32 s63, s62
  s_cmp_lg_u64 vcc, 0
  s_cbranch_scc1 B_mode
B_modedone:
  v_mad_u32_u24 v20, v12, s37, v13
  v_mul_u32_u24 v21, s37, v12
  v_mad_u32_u24 v30, v14, s37, v15
  v_lshrrev_b32 v21, 2, v21
  s_waitcnt lgkmcnt(0)
  v_add_u32 v110, v110, v114
  v_add_u32 v111, v111, v115
  v_add_u32 v112, v112, v116
  v_add_u32 v113, v113, v117
  s_mov_b64 exec, s[40:41]
  ds_write_b32 v110, v118 offset:39488
  s_mov_b64 exec, s[42:43]
  ds_write_b32 v111, v119 offset:39488
  s_mov_b64 exec, s[44:45]
  s_cbranch_execz B_sc2
  ds_write_b32 v112, v120 offset:39488
B_sc2:
  s_mov_b64 exec, s[46:47]
  s_cbranch_execz B_sc3
  ds_write_b32 v113, v121 offset:39488
B_sc3:
  s_mov_b64 exec, -1
  v_readfirstlane_b32 s56, v37
  s_cmp_lg_u32 s56, 0
  s_cbranch_scc1 B_flags
B_noflags:
  s_cmp_gt_u32 s37, 32
  s_cbranch_scc1 B_raw
  s_add_u32 s38, s37, 1
  s_lshr_b32 s38, s38, 1
  s_and_b32 s39, s37, 1
  s_mul_i32 s57, s39, 2
  s_cmp_le_u32 s37, 3
  s_setprio 3
  s_waitcnt lgkmcnt(0)
  s_barrier
  ds_read2_b32 v[22:23], v20 offset0:0 offset1:4
  v_add_u32 v21, 56896, v21
  ds_read2_b32 v[24:25], v21 offset0:0 offset1:1
  ds_read2_b32 v[32:33], v30 offset0:0 offset1:1
  s_cbranch_scc1 B_small
B_start:
  s_waitcnt lgkmcnt(2)
  v_xor_b32 v22, v22, v4
  buffer_load_dwordx4 v[74:77], v22, s[12:15], 0 offen
  buffer_load_dwordx4 v[82:85], v22, s[12:15], 0 offen offset:128
  v_xor_b32 v23, v23, v4
  buffer_load_dwordx4 v[78:81], v23, s[12:15], 0 offen
  buffer_load_dwordx4 v[86:89], v23, s[12:15], 0 offen offset:128
B_started:
  s_waitcnt lgkmcnt(0)
  v_cmp_ne_u32 s[32:33], v32, v33
  v_add_u32 v24, v24, v5
  v_add_u32 v25, v25, v5
  ds_read_b128 v[58:61], v24
  ds_read_b128 v[62:65], v25
  ds_read_b128 v[66:69], v24 offset:128
  ds_read_b128 v[70:73], v25 offset:128
  s_bitset0_b32 s32, 0
  s_bitset0_b32 s33, 0
  s_or_b32 s34, s32, s33
B_u0:
  s_bitcmp1_b32 s34, 0
  s_cbranch_scc1 B_fa0
B_fa0_ret:
  ds_read2_b32 v[26:27], v21 offset0:2 offset1:3
  ds_read2_b32 v[22:23], v20 offset0:8 offset1:12
  s_cmp_le_u32 s38, 1
  s_cbranch_scc1 B_nl0
  s_waitcnt vmcnt(0) lgkmcnt(2)
B_go0:
  v_dot2_f32_bf16 v30, v74, v58, 0
  v_dot2_f32_bf16 v31, v78, v62, 0
  v_dot2_f32_bf16 v30, v75, v59, v30
  v_dot2_f32_bf16 v31, v79, v63, v31
  v_dot2_f32_bf16 v30, v76, v60, v30
  v_dot2_f32_bf16 v31, v80, v64, v31
  v_dot2_f32_bf16 v30, v77, v61, v30
  v_dot2_f32_bf16 v31, v81, v65, v31
  v_dot2_f32_bf16 v30, v82, v66, v30
  v_dot2_f32_bf16 v31, v86, v70, v31
  v_dot2_f32_bf16 v30, v83, v67, v30
  v_dot2_f32_bf16 v31, v87, v71, v31
  v_dot2_f32_bf16 v30, v84, v68, v30
  v_dot2_f32_bf16 v31, v88, v72, v31
  v_dot2_f32_bf16 v30, v85, v69, v30
  v_dot2_f32_bf16 v31, v89, v73, v31
  s_waitcnt lgkmcnt(0)
  s_cmp_le_u32 s38, 1
  s_cbranch_scc1 B_md0
  s_cmp_eq_u32 s38, s57
  v_xor_b32 v22, v22, v4
  buffer_load_dwordx4 v[90:93], v22, s[12:15], 0 offen
  buffer_load_dwordx4 v[98:101], v22, s[12:15], 0 offen offset:128
  s_cbranch_scc1 B_md0
  v_xor_b32 v23, v23, v4
  buffer_load_dwordx4 v[94:97], v23, s[12:15], 0 offen
  buffer_load_dwordx4 v[102:105], v23, s[12:15], 0 offen offset:128
B_md0:
  v_add_u32 v26, v26, v5
  v_add_u32 v27, v27, v5
  ds_read_b128 v[58:61], v26
  ds_read_b128 v[62:65], v27
  ds_read_b128 v[66:69], v26 offset:128
  ds_read_b128 v[70:73], v27 offset:128
  v_permlane32_swap_b32 v30, v31
  s_nop 1
  v_permlane16_swap_b32 v30, v31
  s_nop 1
  v_add_f32_dpp v32, v30, v30 row_half_mirror row_mask:0xf bank_mask:0x5
  v_add_f32_dpp v32, v31, v31 row_half_mirror row_mask:0xf bank_mask:0xa
  s_nop 1
  v_add_f32_dpp v32, v32, v32 quad_perm:[1,0,3,2] row_mask:0xf bank_mask:0xf
  s_nop 1
  v_add_f32_dpp v32, v32, v32 quad_perm:[2,3,0,1] row_mask:0xf bank_mask:0xf
  v_exp_f32 v32, v32
  s_nop 0
  v_add_f32 v32, 1.0, v32
  v_rcp_f32 v32, v32
  s_bitcmp1_b32 s34, 1
  v_cvt_pk_bf16_f32 v32, v32, 0
  s_cbranch_scc1 B_sp0
  s_sub_u32 s38, s38, 1
  v_mov_b32_dpp v38, v32 quad_perm:[0,1,2,3] row_mask:0xf bank_mask:0x5
  v_mov_b32_dpp v39, v32 row_half_mirror row_mask:0xf bank_mask:0xa
  v_mov_b32_dpp v40, v32 row_half_mirror row_mask:0xf bank_mask:0x5
  v_mov_b32_dpp v41, v32 quad_perm:[0,1,2,3] row_mask:0xf bank_mask:0xa
  s_lshr_b32 s34, s34, 2
  s_lshr_b32 s32, s32, 2
  s_lshr_b32 s33, s33, 2
  v_smfmac_f32_16x16x64_bf16 v[50:53], v[38:41], v[74:81], v7
  v_smfmac_f32_16x16x64_bf16 v[54:57], v[38:41], v[82:89], v7
B_sp0_ret:
  s_cmp_lt_u32 s38, 1
  s_cbranch_scc1 B_nf0
  s_setprio 2
  s_cmp_gt_u32 s38, 4
  s_cbranch_scc1 B_pp0
  s_setprio 1
  s_cmp_gt_u32 s38, 2
  s_cbranch_scc1 B_pp0
  s_setprio 0
B_pp0:
B_u1:
  s_bitcmp1_b32 s34, 0
  s_cbranch_scc1 B_fa1
B_fa1_ret:
  ds_read2_b32 v[24:25], v21 offset0:4 offset1:5
  ds_read2_b32 v[22:23], v20 offset0:16 offset1:20
  s_cmp_le_u32 s38, 1
  s_cbranch_scc1 B_nl1
  s_waitcnt vmcnt(0) lgkmcnt(2)
B_go1:
  v_dot2_f32_bf16 v30, v90, v58, 0
  v_dot2_f32_bf16 v31, v94, v62, 0
  v_dot2_f32_bf16 v30, v91, v59, v30
  v_dot2_f32_bf16 v31, v95, v63, v31
  v_dot2_f32_bf16 v30, v92, v60, v30
  v_dot2_f32_bf16 v31, v96, v64, v31
  v_dot2_f32_bf16 v30, v93, v61, v30
  v_dot2_f32_bf16 v31, v97, v65, v31
  v_dot2_f32_bf16 v30, v98, v66, v30
  v_dot2_f32_bf16 v31, v102, v70, v31
  v_dot2_f32_bf16 v30, v99, v67, v30
  v_dot2_f32_bf16 v31, v103, v71, v31
  v_dot2_f32_bf16 v30, v100, v68, v30
  v_dot2_f32_bf16 v31, v104, v72, v31
  v_dot2_f32_bf16 v30, v101, v69, v30
  v_dot2_f32_bf16 v31, v105, v73, v31
  s_waitcnt lgkmcnt(0)
  s_cmp_le_u32 s38, 1
  s_cbranch_scc1 B_md1
  s_cmp_eq_u32 s38, s57
  v_xor_b32 v22, v22, v4
  buffer_load_dwordx4 v[74:77], v22, s[12:15], 0 offen
  buffer_load_dwordx4 v[82:85], v22, s[12:15], 0 offen offset:128
  s_cbranch_scc1 B_md1
  v_xor_b32 v23, v23, v4
  buffer_load_dwordx4 v[78:81], v23, s[12:15], 0 offen
  buffer_load_dwordx4 v[86:89], v23, s[12:15], 0 offen offset:128
B_md1:
  v_add_u32 v24, v24, v5
  v_add_u32 v25, v25, v5
  ds_read_b128 v[58:61], v24
  ds_read_b128 v[62:65], v25
  ds_read_b128 v[66:69], v24 offset:128
  ds_read_b128 v[70:73], v25 offset:128
  v_permlane32_swap_b32 v30, v31
  v_add_u32 v20, 64, v20
  v_add_u32 v21, 16, v21
  v_permlane16_swap_b32 v30, v31
  s_nop 1
  v_add_f32_dpp v32, v30, v30 row_half_mirror row_mask:0xf bank_mask:0x5
  v_add_f32_dpp v32, v31, v31 row_half_mirror row_mask:0xf bank_mask:0xa
  s_nop 1
  v_add_f32_dpp v32, v32, v32 quad_perm:[1,0,3,2] row_mask:0xf bank_mask:0xf
  s_nop 1
  v_add_f32_dpp v32, v32, v32 quad_perm:[2,3,0,1] row_mask:0xf bank_mask:0xf
  v_exp_f32 v32, v32
  s_nop 0
  v_add_f32 v32, 1.0, v32
  v_rcp_f32 v32, v32
  s_bitcmp1_b32 s34, 1
  v_cvt_pk_bf16_f32 v32, v32, 0
  s_cbranch_scc1 B_sp1
  s_sub_u32 s38, s38, 1
  v_mov_b32_dpp v38, v32 quad_perm:[0,1,2,3] row_mask:0xf bank_mask:0x5
  v_mov_b32_dpp v39, v32 row_half_mirror row_mask:0xf bank_mask:0xa
  v_mov_b32_dpp v40, v32 row_half_mirror row_mask:0xf bank_mask:0x5
  v_mov_b32_dpp v41, v32 quad_perm:[0,1,2,3] row_mask:0xf bank_mask:0xa
  s_lshr_b32 s34, s34, 2
  s_lshr_b32 s32, s32, 2
  s_lshr_b32 s33, s33, 2
  v_smfmac_f32_16x16x64_bf16 v[50:53], v[38:41], v[90:97], v7
  v_smfmac_f32_16x16x64_bf16 v[54:57], v[38:41], v[98:105], v7
B_sp1_ret:
  s_cmp_lt_u32 s38, 1
  s_cbranch_scc1 B_nf1
  s_setprio 2
  s_cmp_gt_u32 s38, 4
  s_cbranch_scc1 B_pp1
  s_setprio 1
  s_cmp_gt_u32 s38, 2
  s_cbranch_scc1 B_pp1
  s_setprio 0
B_pp1:
  s_branch B_u0
B_final_flush:
  s_cmp_gt_u32 s36, 7
  s_cbranch_scc1 B_nofr
  s_and_b32 s56, s36, 1
  s_lshl_b32 s56, s56, 7
  s_xor_b32 s56, s56, s72
  v_xor_b32 v30, s56, v8
  v_add_u32 v30, 49408, v30
  v_xor_b32 v31, 64, v30
  v_bfe_u32 v32, v0, 4, 2
  v_lshl_add_u32 v30, v32, 3, v30
  v_lshl_add_u32 v31, v32, 3, v31
  ds_read_b64_tr_b16 v[58:59], v30 offset:0
  ds_read_b64_tr_b16 v[60:61], v30 offset:1024
  ds_read_b64_tr_b16 v[74:75], v30 offset:8
  ds_read_b64_tr_b16 v[76:77], v30 offset:1032
  ds_read_b64_tr_b16 v[62:63], v30 offset:8224
  ds_read_b64_tr_b16 v[64:65], v30 offset:9248
  ds_read_b64_tr_b16 v[78:79], v30 offset:8232
  ds_read_b64_tr_b16 v[80:81], v30 offset:9256
  ds_read_b64_tr_b16 v[66:67], v30 offset:16448
  ds_read_b64_tr_b16 v[68:69], v30 offset:17472
  ds_read_b64_tr_b16 v[82:83], v30 offset:16456
  ds_read_b64_tr_b16 v[84:85], v30 offset:17480
  ds_read_b64_tr_b16 v[70:71], v30 offset:24672
  ds_read_b64_tr_b16 v[72:73], v30 offset:25696
  ds_read_b64_tr_b16 v[86:87], v30 offset:24680
  ds_read_b64_tr_b16 v[88:89], v30 offset:25704
  ds_read_b64_tr_b16 v[90:91], v31 offset:0
  ds_read_b64_tr_b16 v[92:93], v31 offset:1024
  ds_read_b64_tr_b16 v[106:107], v31 offset:8
  ds_read_b64_tr_b16 v[108:109], v31 offset:1032
  ds_read_b64_tr_b16 v[94:95], v31 offset:8224
  ds_read_b64_tr_b16 v[96:97], v31 offset:9248
  ds_read_b64_tr_b16 v[110:111], v31 offset:8232
  ds_read_b64_tr_b16 v[112:113], v31 offset:9256
  ds_read_b64_tr_b16 v[98:99], v31 offset:16448
  ds_read_b64_tr_b16 v[100:101], v31 offset:17472
  ds_read_b64_tr_b16 v[114:115], v31 offset:16456
  ds_read_b64_tr_b16 v[116:117], v31 offset:17480
  ds_read_b64_tr_b16 v[102:103], v31 offset:24672
  ds_read_b64_tr_b16 v[104:105], v31 offset:25696
  ds_read_b64_tr_b16 v[118:119], v31 offset:24680
  ds_read_b64_tr_b16 v[120:121], v31 offset:25704
B_nofr:
  s_waitcnt lgkmcnt(0)
  s_barrier
  s_mov_b64 exec, s[48:49]
  s_cmp_lg_u32 s63, 0
  s_cbranch_scc1 B_final_special
B_final_rmw:
  ds_read_b128 v[22:25], v35
  ds_read_b128 v[26:29], v35 offset:256
  s_waitcnt lgkmcnt(1)
  v_pk_add_f32 v[50:51], v[50:51], v[22:23]
  v_pk_add_f32 v[52:53], v[52:53], v[24:25]
  ds_write_b128 v35, v[50:53]
  s_waitcnt lgkmcnt(1)
  v_pk_add_f32 v[54:55], v[54:55], v[26:27]
  v_pk_add_f32 v[56:57], v[56:57], v[28:29]
  ds_write_b128 v35, v[54:57] offset:256
  s_cmp_eq_u32 s63, 1
  s_cbranch_scc1 B_final_phase2
B_final_done:
  s_mov_b64 exec, -1
B_round_fin:
  s_or_b32 s56, s50, s51
  s_or_b32 s57, s52, s53
  s_or_b32 s56, s56, s57
  s_cbranch_scc1 B_more
  s_mov_b64 s[16:17], s[66:67]
  s_mov_b32 s18, 3200000
  s_mov_b32 s19, 0x20000
  s_mul_i32 s3, s2, 12544
  s_and_b32 s56, s36, 1
  s_lshl_b32 s56, s56, 7
  s_add_u32 s3, s3, s56
  s_cmp_gt_u32 s36, 7
  s_waitcnt lgkmcnt(0)
  s_barrier
  s_cbranch_scc1 B_end
  ds_read_b128 v[22:25], v16 offset:784
  ds_read_b128 v[26:29], v16 offset:800
  ds_read_b128 v[30:33], v16 offset:912
  ds_read_b128 v[34:37], v16 offset:928
  ds_read_b128 v[38:41], v16 offset:1040
  ds_read_b128 v[42:45], v16 offset:1056
  ds_read_b128 v[46:49], v16 offset:1168
  ds_read_b128 v[50:53], v16 offset:1184
  s_waitcnt lgkmcnt(6)
  v_cvt_pk_bf16_f32 v22, v22, v23
  v_cvt_pk_bf16_f32 v23, v24, v25
  v_cvt_pk_bf16_f32 v24, v26, v27
  v_cvt_pk_bf16_f32 v25, v28, v29
  s_nop 1
  v_mfma_f32_16x16x32_bf16 v[4:7], v[58:61], v[22:25], 0
  v_mfma_f32_16x16x32_bf16 v[8:11], v[74:77], v[22:25], 0
  v_mfma_f32_16x16x32_bf16 v[12:15], v[90:93], v[22:25], 0
  v_mfma_f32_16x16x32_bf16 v[54:57], v[106:109], v[22:25], 0
  s_waitcnt lgkmcnt(4)
  v_cvt_pk_bf16_f32 v26, v30, v31
  v_cvt_pk_bf16_f32 v27, v32, v33
  v_cvt_pk_bf16_f32 v28, v34, v35
  v_cvt_pk_bf16_f32 v29, v36, v37
  s_nop 1
  v_mfma_f32_16x16x32_bf16 v[4:7], v[62:65], v[26:29], v[4:7]
  v_mfma_f32_16x16x32_bf16 v[8:11], v[78:81], v[26:29], v[8:11]
  v_mfma_f32_16x16x32_bf16 v[12:15], v[94:97], v[26:29], v[12:15]
  v_mfma_f32_16x16x32_bf16 v[54:57], v[110:113], v[26:29], v[54:57]
  s_waitcnt lgkmcnt(2)
  v_cvt_pk_bf16_f32 v30, v38, v39
  v_cvt_pk_bf16_f32 v31, v40, v41
  v_cvt_pk_bf16_f32 v32, v42, v43
  v_cvt_pk_bf16_f32 v33, v44, v45
  s_nop 1
  v_mfma_f32_16x16x32_bf16 v[4:7], v[66:69], v[30:33], v[4:7]
  v_mfma_f32_16x16x32_bf16 v[8:11], v[82:85], v[30:33], v[8:11]
  v_mfma_f32_16x16x32_bf16 v[12:15], v[98:101], v[30:33], v[12:15]
  v_mfma_f32_16x16x32_bf16 v[54:57], v[114:117], v[30:33], v[54:57]
  s_waitcnt lgkmcnt(0)
  v_cvt_pk_bf16_f32 v34, v46, v47
  v_cvt_pk_bf16_f32 v35, v48, v49
  v_cvt_pk_bf16_f32 v36, v50, v51
  v_cvt_pk_bf16_f32 v37, v52, v53
  s_nop 1
  v_mfma_f32_16x16x32_bf16 v[4:7], v[70:73], v[34:37], v[4:7]
  v_mfma_f32_16x16x32_bf16 v[8:11], v[86:89], v[34:37], v[8:11]
  v_mfma_f32_16x16x32_bf16 v[12:15], v[102:105], v[34:37], v[12:15]
  v_mfma_f32_16x16x32_bf16 v[54:57], v[118:121], v[34:37], v[54:57]
  s_or_b32 s56, s2, s36
  s_nop 4
  v_cvt_pk_bf16_f32 v38, v4, v5
  v_cvt_pk_bf16_f32 v39, v6, v7
  v_cvt_pk_bf16_f32 v40, v8, v9
  v_cvt_pk_bf16_f32 v41, v10, v11
  ds_write_b128 v17, v[38:41] offset:0
  s_nop 0
  v_cvt_pk_bf16_f32 v42, v12, v13
  v_cvt_pk_bf16_f32 v43, v14, v15
  v_cvt_pk_bf16_f32 v44, v54, v55
  v_cvt_pk_bf16_f32 v45, v56, v57
  ds_write_b128 v17, v[42:45] offset:64
  ds_read_b128 v[22:25], v122
  ds_read_b128 v[26:29], v122 offset:1152
  s_waitcnt lgkmcnt(1)
  buffer_store_dwordx4 v[22:25], v18, s[16:19], s3 offen sc1
  s_mov_b64 exec, s[100:101]
  s_cbranch_execz B_nost2
  s_waitcnt lgkmcnt(0)
  buffer_store_dwordx4 v[26:29], v18, s[16:19], s3 offen offset:2048 sc1
B_nost2:
  s_cbranch_scc1 B_end
  v_mov_b32 v4, 0
  v_mov_b32 v5, s35
  s_mov_b64 exec, 1
  global_store_dword v4, v5, s[70:71]
B_end:
B_done:
  s_endpgm
B_fa0:
  s_bitcmp1_b32 s32, 0
  s_cselect_b32 exec_lo, s48, 0
  s_bitcmp1_b32 s33, 0
  s_cselect_b32 exec_hi, s49, 0
  v_add_u32 v34, v27, v6
  s_cmp_ge_u32 s63, 2
  s_cbranch_scc1 B_fa0_at
  s_nop 2
  ds_write_b128 v34, v[50:53]
  ds_write_b128 v34, v[54:57] offset:256
B_fa0_z:
  s_nop 1
  v_mov_b64 v[50:51], 0
  v_mov_b64 v[52:53], 0
  v_mov_b64 v[54:55], 0
  v_mov_b64 v[56:57], 0
  s_mov_b64 exec, -1
  s_branch B_fa0_ret
B_fa0_at:
  s_nop 2
  ds_add_f32 v34, v50 offset:0
  ds_add_f32 v34, v51 offset:4
  ds_add_f32 v34, v52 offset:8
  ds_add_f32 v34, v53 offset:12
  ds_add_f32 v34, v54 offset:256
  ds_add_f32 v34, v55 offset:260
  ds_add_f32 v34, v56 offset:264
  ds_add_f32 v34, v57 offset:268
  s_branch B_fa0_z
B_nl0:
  s_lshl_b32 s56, s39, 1
  s_or_b32 s34, s34, s56
  s_waitcnt vmcnt(0) lgkmcnt(2)
  s_branch B_go0
B_sp0:
  s_sub_u32 s38, s38, 1
  v_mov_b32_dpp v42, v32 quad_perm:[0,1,2,3] row_mask:0x3 bank_mask:0x5
  v_mov_b32_dpp v43, v32 row_half_mirror row_mask:0x3 bank_mask:0xa
  v_mov_b32_dpp v44, v32 row_half_mirror row_mask:0x3 bank_mask:0x5
  v_mov_b32_dpp v45, v32 quad_perm:[0,1,2,3] row_mask:0x3 bank_mask:0xa
  v_mov_b32_dpp v46, v32 quad_perm:[0,1,2,3] row_mask:0xc bank_mask:0x5
  v_mov_b32_dpp v47, v32 row_half_mirror row_mask:0xc bank_mask:0xa
  v_mov_b32_dpp v48, v32 row_half_mirror row_mask:0xc bank_mask:0x5
  v_mov_b32_dpp v49, v32 quad_perm:[0,1,2,3] row_mask:0xc bank_mask:0xa
  s_add_u32 s56, s38, 1
  s_cmp_eq_u32 s56, s39
  v_smfmac_f32_16x16x64_bf16 v[50:53], v[42:45], v[74:81], v7
  v_smfmac_f32_16x16x64_bf16 v[54:57], v[42:45], v[82:89], v7
  s_cbranch_scc1 B_odd0
  s_nop 0
B_sp0_f:
  s_bitcmp1_b32 s32, 1
  s_cselect_b32 exec_lo, s48, 0
  s_bitcmp1_b32 s33, 1
  s_cselect_b32 exec_hi, s49, 0
  v_add_u32 v34, v24, v6
  s_cmp_ge_u32 s63, 2
  s_cbranch_scc1 B_sp0_f_at
  s_nop 2
  ds_write_b128 v34, v[50:53]
  ds_write_b128 v34, v[54:57] offset:256
B_sp0_f_z:
  s_nop 1
  v_mov_b64 v[50:51], 0
  v_mov_b64 v[52:53], 0
  v_mov_b64 v[54:55], 0
  v_mov_b64 v[56:57], 0
  s_mov_b64 exec, -1
  s_lshr_b32 s34, s34, 2
  s_lshr_b32 s32, s32, 2
  s_lshr_b32 s33, s33, 2
  v_smfmac_f32_16x16x64_bf16 v[50:53], v[46:49], v[74:81], v7
  v_smfmac_f32_16x16x64_bf16 v[54:57], v[46:49], v[82:89], v7
  s_branch B_sp0_ret
B_sp0_f_at:
  s_nop 2
  ds_add_f32 v34, v50 offset:0
  ds_add_f32 v34, v51 offset:4
  ds_add_f32 v34, v52 offset:8
  ds_add_f32 v34, v53 offset:12
  ds_add_f32 v34, v54 offset:256
  ds_add_f32 v34, v55 offset:260
  ds_add_f32 v34, v56 offset:264
  ds_add_f32 v34, v57 offset:268
  s_branch B_sp0_f_z
B_odd0:
  v_add_u32 v35, v24, v6
  s_branch B_final_flush
B_nf0:
  s_cmp_lg_u32 s38, 0
  s_cbranch_scc1 B_u1
  v_add_u32 v35, v25, v6
  s_branch B_final_flush
B_fa1:
  s_bitcmp1_b32 s32, 0
  s_cselect_b32 exec_lo, s48, 0
  s_bitcmp1_b32 s33, 0
  s_cselect_b32 exec_hi, s49, 0
  v_add_u32 v34, v25, v6
  s_cmp_ge_u32 s63, 2
  s_cbranch_scc1 B_fa1_at
  s_nop 2
  ds_write_b128 v34, v[50:53]
  ds_write_b128 v34, v[54:57] offset:256
B_fa1_z:
  s_nop 1
  v_mov_b64 v[50:51], 0
  v_mov_b64 v[52:53], 0
  v_mov_b64 v[54:55], 0
  v_mov_b64 v[56:57], 0
  s_mov_b64 exec, -1
  s_branch B_fa1_ret
B_fa1_at:
  s_nop 2
  ds_add_f32 v34, v50 offset:0
  ds_add_f32 v34, v51 offset:4
  ds_add_f32 v34, v52 offset:8
  ds_add_f32 v34, v53 offset:12
  ds_add_f32 v34, v54 offset:256
  ds_add_f32 v34, v55 offset:260
  ds_add_f32 v34, v56 offset:264
  ds_add_f32 v34, v57 offset:268
  s_branch B_fa1_z
B_nl1:
  s_lshl_b32 s56, s39, 1
  s_or_b32 s34, s34, s56
  s_waitcnt vmcnt(0) lgkmcnt(2)
  s_branch B_go1
B_sp1:
  s_sub_u32 s38, s38, 1
  v_mov_b32_dpp v42, v32 quad_perm:[0,1,2,3] row_mask:0x3 bank_mask:0x5
  v_mov_b32_dpp v43, v32 row_half_mirror row_mask:0x3 bank_mask:0xa
  v_mov_b32_dpp v44, v32 row_half_mirror row_mask:0x3 bank_mask:0x5
  v_mov_b32_dpp v45, v32 quad_perm:[0,1,2,3] row_mask:0x3 bank_mask:0xa
  v_mov_b32_dpp v46, v32 quad_perm:[0,1,2,3] row_mask:0xc bank_mask:0x5
  v_mov_b32_dpp v47, v32 row_half_mirror row_mask:0xc bank_mask:0xa
  v_mov_b32_dpp v48, v32 row_half_mirror row_mask:0xc bank_mask:0x5
  v_mov_b32_dpp v49, v32 quad_perm:[0,1,2,3] row_mask:0xc bank_mask:0xa
  s_add_u32 s56, s38, 1
  s_cmp_eq_u32 s56, s39
  v_smfmac_f32_16x16x64_bf16 v[50:53], v[42:45], v[90:97], v7
  v_smfmac_f32_16x16x64_bf16 v[54:57], v[42:45], v[98:105], v7
  s_cbranch_scc1 B_odd1
  s_nop 0
B_sp1_f:
  s_bitcmp1_b32 s32, 1
  s_cselect_b32 exec_lo, s48, 0
  s_bitcmp1_b32 s33, 1
  s_cselect_b32 exec_hi, s49, 0
  v_add_u32 v34, v26, v6
  s_cmp_ge_u32 s63, 2
  s_cbranch_scc1 B_sp1_f_at
  s_nop 2
  ds_write_b128 v34, v[50:53]
  ds_write_b128 v34, v[54:57] offset:256
B_sp1_f_z:
  s_nop 1
  v_mov_b64 v[50:51], 0
  v_mov_b64 v[52:53], 0
  v_mov_b64 v[54:55], 0
  v_mov_b64 v[56:57], 0
  s_mov_b64 exec, -1
  s_lshr_b32 s34, s34, 2
  s_lshr_b32 s32, s32, 2
  s_lshr_b32 s33, s33, 2
  v_smfmac_f32_16x16x64_bf16 v[50:53], v[46:49], v[90:97], v7
  v_smfmac_f32_16x16x64_bf16 v[54:57], v[46:49], v[98:105], v7
  s_branch B_sp1_ret
B_sp1_f_at:
  s_nop 2
  ds_add_f32 v34, v50 offset:0
  ds_add_f32 v34, v51 offset:4
  ds_add_f32 v34, v52 offset:8
  ds_add_f32 v34, v53 offset:12
  ds_add_f32 v34, v54 offset:256
  ds_add_f32 v34, v55 offset:260
  ds_add_f32 v34, v56 offset:264
  ds_add_f32 v34, v57 offset:268
  s_branch B_sp1_f_z
B_odd1:
  v_add_u32 v35, v26, v6
  s_branch B_final_flush
B_nf1:
  s_cmp_lg_u32 s38, 0
  s_cbranch_scc1 B_u0
  v_add_u32 v35, v27, v6
  s_branch B_final_flush
B_small:
  s_waitcnt lgkmcnt(0)
  s_cmp_eq_u32 s37, 0
  s_cbranch_scc1 B_empty
  v_mov_b32 v78, 0
  v_mov_b32 v79, 0
  v_mov_b32 v80, 0
  v_mov_b32 v81, 0
  v_mov_b32 v86, 0
  v_mov_b32 v87, 0
  v_mov_b32 v88, 0
  v_mov_b32 v89, 0
  v_mov_b32 v94, 0
  v_mov_b32 v95, 0
  v_mov_b32 v96, 0
  v_mov_b32 v97, 0
  v_mov_b32 v102, 0
  v_mov_b32 v103, 0
  v_mov_b32 v104, 0
  v_mov_b32 v105, 0
  s_cmp_ge_u32 s37, 2
  s_cbranch_scc1 B_start
  v_xor_b32 v22, v22, v4
  buffer_load_dwordx4 v[74:77], v22, s[12:15], 0 offen
  buffer_load_dwordx4 v[82:85], v22, s[12:15], 0 offen offset:128
  s_branch B_started
B_empty:
  s_waitcnt vmcnt(0)
  s_barrier
  s_cmp_gt_u32 s36, 7
  s_cbranch_scc1 B_nofr2
  s_and_b32 s56, s36, 1
  s_lshl_b32 s56, s56, 7
  s_xor_b32 s56, s56, s72
  v_xor_b32 v30, s56, v8
  v_add_u32 v30, 49408, v30
  v_xor_b32 v31, 64, v30
  v_bfe_u32 v32, v0, 4, 2
  v_lshl_add_u32 v30, v32, 3, v30
  v_lshl_add_u32 v31, v32, 3, v31
  ds_read_b64_tr_b16 v[58:59], v30 offset:0
  ds_read_b64_tr_b16 v[60:61], v30 offset:1024
  ds_read_b64_tr_b16 v[74:75], v30 offset:8
  ds_read_b64_tr_b16 v[76:77], v30 offset:1032
  ds_read_b64_tr_b16 v[62:63], v30 offset:8224
  ds_read_b64_tr_b16 v[64:65], v30 offset:9248
  ds_read_b64_tr_b16 v[78:79], v30 offset:8232
  ds_read_b64_tr_b16 v[80:81], v30 offset:9256
  ds_read_b64_tr_b16 v[66:67], v30 offset:16448
  ds_read_b64_tr_b16 v[68:69], v30 offset:17472
  ds_read_b64_tr_b16 v[82:83], v30 offset:16456
  ds_read_b64_tr_b16 v[84:85], v30 offset:17480
  ds_read_b64_tr_b16 v[70:71], v30 offset:24672
  ds_read_b64_tr_b16 v[72:73], v30 offset:25696
  ds_read_b64_tr_b16 v[86:87], v30 offset:24680
  ds_read_b64_tr_b16 v[88:89], v30 offset:25704
  ds_read_b64_tr_b16 v[90:91], v31 offset:0
  ds_read_b64_tr_b16 v[92:93], v31 offset:1024
  ds_read_b64_tr_b16 v[106:107], v31 offset:8
  ds_read_b64_tr_b16 v[108:109], v31 offset:1032
  ds_read_b64_tr_b16 v[94:95], v31 offset:8224
  ds_read_b64_tr_b16 v[96:97], v31 offset:9248
  ds_read_b64_tr_b16 v[110:111], v31 offset:8232
  ds_read_b64_tr_b16 v[112:113], v31 offset:9256
  ds_read_b64_tr_b16 v[98:99], v31 offset:16448
  ds_read_b64_tr_b16 v[100:101], v31 offset:17472
  ds_read_b64_tr_b16 v[114:115], v31 offset:16456
  ds_read_b64_tr_b16 v[116:117], v31 offset:17480
  ds_read_b64_tr_b16 v[102:103], v31 offset:24672
  ds_read_b64_tr_b16 v[104:105], v31 offset:25696
  ds_read_b64_tr_b16 v[118:119], v31 offset:24680
  ds_read_b64_tr_b16 v[120:121], v31 offset:25704
B_nofr2:
  s_branch B_round_fin
B_flags:
  s_cmp_lg_u32 s62, 0
  s_cbranch_scc1 B_noflags
  s_bitcmp1_b32 s56, 3
  s_cbranch_scc1 B_raw
  v_mov_b32 v34, 39456
  ds_read_b128 v[34:37], v34
  s_waitcnt lgkmcnt(0)
  v_readfirstlane_b32 s53, v37
  v_readfirstlane_b32 s50, v34
  v_readfirstlane_b32 s51, v35
  v_readfirstlane_b32 s52, v36
  s_branch B_noflags
B_qnmore:
  v_add_u32 v30, 64, v30
  s_branch B_qn
B_mode:
  s_max_u32 s37, s37, 13
  v_cvt_f32_u32 v34, s37
  v_lshrrev_b32 v35, 4, v32
  v_rcp_f32 v34, v34
  v_add_u32 v36, v35, v31
  v_cvt_f32_u32 v35, v35
  v_cvt_f32_u32 v36, v36
  v_add_f32 v35, 0.5, v35
  v_add_f32 v36, 0.5, v36
  v_mul_f32 v35, v35, v34
  v_mul_f32 v36, v36, v34
  v_cvt_u32_f32 v35, v35
  v_cvt_u32_f32 v36, v36
  v_sub_u32 v35, v36, v35
  v_cmp_lt_u32 vcc, 1, v35
  v_cmp_lt_u32 s[58:59], 2, v35
  s_cmp_lg_u64 vcc, 0
  s_cselect_b32 s56, 1, 0
  s_max_u32 s63, s63, s56
  s_cmp_lg_u64 s[58:59], 0
  s_cselect_b32 s56, 2, 0
  s_max_u32 s63, s63, s56
  s_branch B_modedone
B_final_phase2:
  s_waitcnt lgkmcnt(0)
  s_barrier
  s_mov_b32 exec_lo, 0
  s_mov_b32 exec_hi, s49
  s_mov_b32 s63, 0
  s_branch B_final_rmw
B_final_special:
  s_cmp_ge_u32 s63, 2
  s_cbranch_scc1 B_final_atomic
  s_mov_b32 exec_hi, 0
  s_branch B_final_rmw
B_final_atomic:
  v_cmp_le_u32 vcc, 784, v35
  s_and_b64 exec, exec, vcc
  ds_add_f32 v35, v50 offset:0
  ds_add_f32 v35, v51 offset:4
  ds_add_f32 v35, v52 offset:8
  ds_add_f32 v35, v53 offset:12
  ds_add_f32 v35, v54 offset:256
  ds_add_f32 v35, v55 offset:260
  ds_add_f32 v35, v56 offset:264
  ds_add_f32 v35, v57 offset:268
  s_branch B_final_done
B_mark:
  s_mov_b64 exec, vcc
  v_lshrrev_b32 v30, 3, v0
  v_mov_b32 v31, 1
  v_lshlrev_b32 v31, v30, v31
  v_lshrrev_b32 v30, 5, v30
  v_lshlrev_b32 v30, 2, v30
  ds_or_b32 v30, v31 offset:39456
  ds_or_b32 v126, v126 offset:39468
  s_mov_b64 exec, -1
  v_and_b32 v114, 0xfc, v114
  v_and_b32 v115, 0xfc, v115
  v_and_b32 v116, 0xfc, v116
  v_and_b32 v117, 0xfc, v117
  s_branch B_nomark
F_idle:
  s_mov_b64 exec, -1
  s_lshl_b32 s56, s36, 10
  s_add_u32 m0, s56, 98560
  s_mul_i32 s57, s2, 12544
  s_cmp_gt_u32 s36, 12
  s_cbranch_scc1 F_nx2
  buffer_load_dwordx4 v3, s[12:15], s57 offen lds
F_nx2:
  s_branch F_placed
F_ovf:
  s_add_u32 s20, s70, 0x900000
  s_addc_u32 s21, s71, 0
  s_mov_b32 s22, 2097664
  s_mov_b32 s23, 0x20000
  v_mov_b32 v35, 33792
  s_mul_i32 s3, s2, 12544
  v_cmp_lt_u32 vcc, s58, v90
  s_mov_b64 exec, vcc
  s_cbranch_execz F_ov0
  ds_add_rtn_u32 v37, v35, v34
  v_lshl_or_b32 v86, v78, 14, v74
  s_waitcnt lgkmcnt(0)
  buffer_store_dword v86, v37, s[20:23], s3 offen sc1
  s_nop 0
  v_lshlrev_b32 v86, 5, v82
  v_mov_b32 v82, 1152
F_ov0:
  s_mov_b64 exec, s[40:41]
  v_cmp_lt_u32 vcc, s58, v91
  s_mov_b64 exec, vcc
  s_cbranch_execz F_ov1
  ds_add_rtn_u32 v37, v35, v34
  v_lshl_or_b32 v87, v79, 14, v75
  s_waitcnt lgkmcnt(0)
  buffer_store_dword v87, v37, s[20:23], s3 offen sc1
  s_nop 0
  v_lshlrev_b32 v87, 5, v83
  v_mov_b32 v83, 1152
F_ov1:
  s_mov_b64 exec, s[40:41]
  v_cmp_lt_u32 vcc, s58, v92
  s_mov_b64 exec, vcc
  s_cbranch_execz F_ov2
  ds_add_rtn_u32 v37, v35, v34
  v_lshl_or_b32 v88, v80, 14, v76
  s_waitcnt lgkmcnt(0)
  buffer_store_dword v88, v37, s[20:23], s3 offen sc1
  s_nop 0
  v_lshlrev_b32 v88, 5, v84
  v_mov_b32 v84, 1152
F_ov2:
  s_mov_b64 exec, s[40:41]
  v_cmp_lt_u32 vcc, s58, v93
  s_mov_b64 exec, vcc
  s_cbranch_execz F_ov3
  ds_add_rtn_u32 v37, v35, v34
  v_lshl_or_b32 v89, v81, 14, v77
  s_waitcnt lgkmcnt(0)
  buffer_store_dword v89, v37, s[20:23], s3 offen sc1
  s_nop 0
  v_lshlrev_b32 v89, 5, v85
  v_mov_b32 v85, 1152
F_ov3:
  s_mov_b64 exec, s[40:41]
  s_waitcnt vmcnt(0)
  s_branch F_ovfdone
F_cnt:
  v_mov_b32 v35, 36864
  v_mov_b32 v36, 64
  s_mov_b64 exec, s[40:41]
  v_cmp_le_u32 vcc, v35, v90
  s_mov_b64 exec, vcc
  ds_or_b32 v86, v36
  s_mov_b64 exec, s[40:41]
  v_cmp_le_u32 vcc, v35, v91
  s_mov_b64 exec, vcc
  ds_or_b32 v87, v36
  s_mov_b64 exec, s[40:41]
  v_cmp_le_u32 vcc, v35, v92
  s_mov_b64 exec, vcc
  ds_or_b32 v88, v36
  s_mov_b64 exec, s[40:41]
  v_cmp_le_u32 vcc, v35, v93
  s_mov_b64 exec, vcc
  ds_or_b32 v89, v36
  s_mov_b64 exec, -1
  s_cmp_lg_u32 s36, 0
  s_cbranch_scc1 F_cnt2
  s_add_u32 s20, s70, 0x900000
  s_addc_u32 s21, s71, 0
  s_mov_b32 s22, 2097664
  s_mov_b32 s23, 0x20000
  s_lshl_b32 s99, s2, 2
  s_add_u32 s99, s99, 0x200000
  v_mov_b32 v84, 0
  v_lshrrev_b32 v82, 2, v82
  s_mov_b64 exec, 1
  buffer_store_dword v82, v84, s[20:23], s99 offen sc1
  s_mov_b64 exec, -1
  s_waitcnt vmcnt(0)
F_cnt2:
  s_waitcnt lgkmcnt(0)
  s_barrier
  ds_read_b128 v[74:77], v119
  ds_read_b128 v[78:81], v119 offset:1024
  s_branch F_cntdone
F_giveup:
  s_waitcnt vmcnt(0)
  s_mov_b64 exec, -1
  v_mov_b32 v31, 8
  ds_or_b32 v126, v31 offset:39468
  v_mov_b32 v106, 0
  v_mov_b32 v107, 0
  v_mov_b32 v108, 0
  v_mov_b32 v109, 0
  s_branch F_polled
B_raw:
  s_mov_b32 s50, -1
  s_mov_b32 s51, -1
  s_mov_b32 s52, -1
  s_mov_b32 s53, 0xffffffff
  s_mov_b32 s62, 3
B_more:
  s_waitcnt vmcnt(0) lgkmcnt(0)
  s_barrier
  s_ff1_i32_b32 s56, s50
  s_cmp_lg_u32 s50, 0
  s_cbranch_scc0 B_m1
  s_bitset0_b32 s50, s56
  s_branch B_mdone
B_m1:
  s_ff1_i32_b32 s56, s51
  s_cmp_lg_u32 s51, 0
  s_cbranch_scc0 B_m2
  s_bitset0_b32 s51, s56
  s_add_u32 s56, s56, 32
  s_branch B_mdone
B_m2:
  s_ff1_i32_b32 s56, s52
  s_cmp_lg_u32 s52, 0
  s_cbranch_scc0 B_m3
  s_bitset0_b32 s52, s56
  s_add_u32 s56, s56, 64
  s_branch B_mdone
B_m3:
  s_ff1_i32_b32 s56, s53
  s_bitset0_b32 s53, s56
  s_add_u32 s56, s56, 96
B_mdone:
  s_mul_i32 s57, s56, 12544
  s_cmp_eq_u32 s62, 3
  s_cbranch_scc1 B_mraw
  s_mov_b32 s62, 2
  s_add_u32 s20, s70, 0x900000
  s_addc_u32 s21, s71, 0
  s_mov_b32 s22, 2097664
  s_mov_b32 s23, 0x20000
  s_lshl_b32 s58, s56, 2
  s_add_u32 s58, s58, 0x200000
  v_mov_b32 v30, 0
  buffer_load_dword v31, v30, s[20:23], s58 offen sc1
  buffer_load_dwordx4 v[106:109], v1, s[20:23], s57 offen sc1
  s_waitcnt vmcnt(0)
  v_readfirstlane_b32 s60, v31
  s_branch B_mgot
B_mraw:
  s_mov_b64 s[20:21], s[8:9]
  s_mov_b32 s22, 1600000
  s_mov_b32 s23, 0x20000
  buffer_load_dwordx4 v[106:109], v1, s[20:23], s57 offen
  s_waitcnt vmcnt(0)
  s_mov_b64 s[20:21], s[6:7]
  buffer_load_dwordx4 v[110:113], v1, s[20:23], s57 offen
  s_cmp_eq_u32 s56, 127
  s_movk_i32 s60, 3136
  s_cselect_b32 s60, 1728, s60
  s_waitcnt vmcnt(0)
  v_lshl_or_b32 v106, v110, 14, v106
  v_lshl_or_b32 v107, v111, 14, v107
  v_lshl_or_b32 v108, v112, 14, v108
  v_lshl_or_b32 v109, v113, 14, v109
B_mgot:
  v_mov_b32 v50, 0
  v_mov_b32 v51, 0
  v_mov_b32 v52, 0
  v_mov_b32 v53, 0
  v_mov_b32 v54, 0
  v_mov_b32 v55, 0
  v_mov_b32 v56, 0
  v_mov_b32 v57, 0
  v_cmp_gt_u32 vcc, 16, v0
  s_mov_b64 exec, vcc
  ds_write_b128 v1, v[50:53] offset:39200
  s_mov_b64 exec, -1
  ds_write_b128 v1, v[50:53] offset:39488
  ds_write_b128 v1, v[50:53] offset:49152
  s_mul_i32 s61, s2, 49
  s_sub_u32 s61, s61, 1
  v_lshlrev_b32 v30, 2, v0
  s_min_u32 s60, s60, 3136
  v_and_b32 v31, 0x3fff, v106
  v_subrev_u32 v31, s61, v31
  v_lshrrev_b32 v106, 14, v106
  v_lshl_or_b32 v106, v106, 8, v31
  v_add_u32 v32, 0, v30
  v_cmp_gt_u32 vcc, s60, v32
  v_add_u32 v31, -1, v31
  v_cmp_gt_u32 s[56:57], 49, v31
  s_and_b64 vcc, vcc, s[56:57]
  s_nop 1
  v_cndmask_b32 v106, 0, v106, vcc
  v_and_b32 v31, 0x3fff, v107
  v_subrev_u32 v31, s61, v31
  v_lshrrev_b32 v107, 14, v107
  v_lshl_or_b32 v107, v107, 8, v31
  v_add_u32 v32, 1, v30
  v_cmp_gt_u32 vcc, s60, v32
  v_add_u32 v31, -1, v31
  v_cmp_gt_u32 s[56:57], 49, v31
  s_and_b64 vcc, vcc, s[56:57]
  s_nop 1
  v_cndmask_b32 v107, 0, v107, vcc
  v_and_b32 v31, 0x3fff, v108
  v_subrev_u32 v31, s61, v31
  v_lshrrev_b32 v108, 14, v108
  v_lshl_or_b32 v108, v108, 8, v31
  v_add_u32 v32, 2, v30
  v_cmp_gt_u32 vcc, s60, v32
  v_add_u32 v31, -1, v31
  v_cmp_gt_u32 s[56:57], 49, v31
  s_and_b64 vcc, vcc, s[56:57]
  s_nop 1
  v_cndmask_b32 v108, 0, v108, vcc
  v_and_b32 v31, 0x3fff, v109
  v_subrev_u32 v31, s61, v31
  v_lshrrev_b32 v109, 14, v109
  v_lshl_or_b32 v109, v109, 8, v31
  v_add_u32 v32, 3, v30
  v_cmp_gt_u32 vcc, s60, v32
  v_add_u32 v31, -1, v31
  v_cmp_gt_u32 s[56:57], 49, v31
  s_and_b64 vcc, vcc, s[56:57]
  s_nop 1
  v_cndmask_b32 v109, 0, v109, vcc
  s_waitcnt lgkmcnt(0)
  s_barrier
  s_branch B_build
F_code_end:
.section .rodata,"a"
.p2align 6
.amdhsa_kernel standalone__kernel_systems_refs_featgraph__graph_kernel
  .amdhsa_next_free_vgpr 128
  .amdhsa_next_free_sgpr 102
  .amdhsa_accum_offset 128
  .amdhsa_group_segment_fixed_size 0
  .amdhsa_kernarg_size 64
  .amdhsa_user_sgpr_count 2
  .amdhsa_user_sgpr_kernarg_segment_ptr 1
  .amdhsa_system_sgpr_workgroup_id_x 1
.end_amdhsa_kernel
```
